```python
import torch

def _softmax(x, axis=-1):
    return torch.softmax(x, dim=axis)
def _gelu(x):
    return torch.nn.functional.gelu(x, approximate="tanh")
def _silu(x):
    return torch.nn.functional.silu(x)
def _sigmoid(x):
    return torch.sigmoid(x)
def _layernorm(x, axis=-1, eps=1e-5):
    m = x.mean(dim=axis, keepdim=True)
    v = x.var(dim=axis, keepdim=True, unbiased=False)
    return (x - m) / torch.sqrt(v + eps)
def _scatter_add(tgt, idx, src, axis=0):
    return tgt.clone().index_add_(axis, idx, src)
def _segment_sum(src, seg, n):
    out = torch.zeros((n,) + src.shape[1:], dtype=src.dtype)
    return out.index_add_(0, seg, src)
def _pad(x, pw):
    flat = tuple(v for pair in reversed(pw) for v in pair)
    return torch.nn.functional.pad(x, flat)

kernel_name = 'standalone__mha_softmax__decode'

def setup_inputs():

    _w = (lambda a: (lambda t: t.to(torch.bfloat16) if t.is_floating_point() else t)(torch.as_tensor(a)))
    B, H, Sq, Sk, D = 8, 32, 1, 4096, 128
    return {
        "q": _w((lambda *s: torch.randn(*s, dtype=torch.bfloat16) * 0.8)(B, H, Sq, D)),
        "k": _w((lambda *s: torch.randn(*s, dtype=torch.bfloat16) * 0.8)(B, H, Sk, D)),
        "v": _w((lambda *s: torch.randn(*s, dtype=torch.bfloat16) * 0.05)(B, H, Sk, D)),
    }

def reference(q, k, v):
    scale = q.shape[-1] ** -0.5
    scores = torch.einsum("bhqd,bhkd->bhqk", q, k) * scale
    p = _softmax(scores, axis=-1)
    return torch.einsum("bhqk,bhkd->bhqd", p, v)
```

```asm
; @launch grid=(256,1,1) block=(384,1,1) lds=86144
.amdgcn_target "amdgcn-amd-amdhsa--gfx950"
.text
.globl standalone__mha_softmax__decode_kernel
.p2align 12
.p2align 8
.type standalone__mha_softmax__decode_kernel,@function
standalone__mha_softmax__decode_kernel:
    s_load_dwordx8 s[24:31], s[0:1], 0
    v_readfirstlane_b32 s3, v0
    s_cmp_ge_u32 s2, 256
    s_cbranch_scc1 L_end
    s_cmp_ge_u32 s3, 320
    s_cbranch_scc1 L_ctrl
    s_cmp_ge_u32 s3, 64
    s_cbranch_scc1 L_cons
    s_bitcmp1_b32 s2, 0
    s_cselect_b32 s12, 0x9586400, 0
    s_bitcmp1_b32 s2, 1
    s_cselect_b32 s13, 0xc0ca300, 0
    s_xor_b32 s12, s12, s13
    s_bitcmp1_b32 s2, 2
    s_cselect_b32 s13, 0x9424200, 0
    s_xor_b32 s12, s12, s13
    s_bitcmp1_b32 s2, 3
    s_cselect_b32 s13, 0xca8d900, 0
    s_xor_b32 s12, s12, s13
    s_bitcmp1_b32 s2, 4
    s_cselect_b32 s13, 0x1baa700, 0
    s_xor_b32 s12, s12, s13
    s_bitcmp1_b32 s2, 5
    s_cselect_b32 s13, 0xa0e1400, 0
    s_xor_b32 s12, s12, s13
    s_bitcmp1_b32 s2, 6
    s_cselect_b32 s13, 0x5666000, 0
    s_xor_b32 s12, s12, s13
    s_bitcmp1_b32 s2, 7
    s_cselect_b32 s13, 0x8917900, 0
    s_xor_b32 s12, s12, s13
    v_and_b32 v1, 15, v0
    s_and_b32 s13, s12, 0xfffff
    v_lshl_or_b32 v1, v1, 4, s13
    v_bfe_i32 v2, v0, 4, 1
    v_and_b32 v2, 0x17900, v2
    v_xor_b32 v1, v1, v2
    v_bfe_i32 v2, v0, 5, 1
    v_and_b32 v2, 0x89000, v2
    v_xor_b32 v1, v1, v2
    v_xor_b32 v2, 0x95b00, v1
    v_xor_b32 v3, 0xd5a00, v1
    v_xor_b32 v4, 0xd5a00, v2
    v_xor_b32 v5, 0x8100, v1
    v_xor_b32 v6, 0x8100, v2
    v_xor_b32 v7, 0x8100, v3
    v_xor_b32 v8, 0x8100, v4
    s_xor_b32 s12, s12, s13
    s_mov_b32 s10, 0x100000
    s_mov_b32 s11, 0x20000
    s_mov_b32 m0, 0
    s_mov_b32 s15, 0
    s_mov_b32 s17, 0x59d00
    s_mov_b32 s18, 0x69600
    v_writelane_b32 v11, s17, 0
    v_writelane_b32 v11, s18, 1
    s_setprio 3
    s_waitcnt lgkmcnt(0)
    s_add_u32 s8, s26, s12
    s_addc_u32 s9, s27, 0
L_free:
    buffer_load_dwordx4 v1, s[8:11], 0 offen nt lds
    s_addk_i32 m0, 1024
    v_xor_b32 v1, s17, v1
    buffer_load_dwordx4 v2, s[8:11], 0 offen nt lds
    s_addk_i32 m0, 1024
    v_xor_b32 v2, s17, v2
    buffer_load_dwordx4 v3, s[8:11], 0 offen nt lds
    s_addk_i32 m0, 1024
    v_xor_b32 v3, s17, v3
    buffer_load_dwordx4 v4, s[8:11], 0 offen nt lds
    s_addk_i32 m0, 1024
    v_xor_b32 v4, s17, v4
    buffer_load_dwordx4 v5, s[8:11], 0 offen nt lds
    s_addk_i32 m0, 1024
    v_xor_b32 v5, s17, v5
    buffer_load_dwordx4 v6, s[8:11], 0 offen nt lds
    s_addk_i32 m0, 1024
    v_xor_b32 v6, s17, v6
    buffer_load_dwordx4 v7, s[8:11], 0 offen nt lds
    s_addk_i32 m0, 1024
    v_xor_b32 v7, s17, v7
    buffer_load_dwordx4 v8, s[8:11], 0 offen nt lds
    s_addk_i32 m0, 1024
    v_xor_b32 v8, s17, v8
    s_add_u32 s18, s15, 2
    s_bitset1_b32 s18, 7
    s_ff1_i32_b32 s18, s18
    v_readlane_b32 s17, v11, s18
    s_bitset0_b32 m0, 16
    s_add_u32 s15, s15, 1
    s_cmp_eq_u32 s15, 1
    s_cbranch_scc1 L_free
L_go:
    v_mov_b32 v9, 81952
    v_mov_b32 v10, 3
    ds_write_b32 v9, v10
L_ld3:
    s_waitcnt vmcnt(21)
    buffer_load_dwordx4 v1, s[8:11], 0 offen nt lds
    s_addk_i32 m0, 1024
    v_xor_b32 v1, s17, v1
    s_cmp_lt_u32 s15, 4
    s_cbranch_scc1 L_tab
    s_barrier
L_nb:
    s_waitcnt vmcnt(21)
    buffer_load_dwordx4 v2, s[8:11], 0 offen nt lds
    s_addk_i32 m0, 1024
    v_xor_b32 v2, s17, v2
    s_waitcnt vmcnt(21)
    buffer_load_dwordx4 v3, s[8:11], 0 offen nt lds
    s_addk_i32 m0, 1024
    v_xor_b32 v3, s17, v3
    ds_read_b32 v10, v9
    s_waitcnt vmcnt(21)
    buffer_load_dwordx4 v4, s[8:11], 0 offen nt lds
    s_addk_i32 m0, 1024
    v_xor_b32 v4, s17, v4
    s_waitcnt vmcnt(21)
    buffer_load_dwordx4 v5, s[8:11], 0 offen nt lds
    s_addk_i32 m0, 1024
    v_xor_b32 v5, s17, v5
    s_waitcnt vmcnt(21)
    buffer_load_dwordx4 v6, s[8:11], 0 offen nt lds
    s_addk_i32 m0, 1024
    v_xor_b32 v6, s17, v6
    s_waitcnt vmcnt(21)
    buffer_load_dwordx4 v7, s[8:11], 0 offen nt lds
    s_addk_i32 m0, 1024
    v_xor_b32 v7, s17, v7
    s_waitcnt vmcnt(21)
    buffer_load_dwordx4 v8, s[8:11], 0 offen nt lds
    s_addk_i32 m0, 1024
    v_xor_b32 v8, s17, v8
L_next:
    s_waitcnt lgkmcnt(0)
    v_readfirstlane_b32 s16, v10
    s_add_u32 s18, s15, 2
    s_bitset1_b32 s18, 7
    s_ff1_i32_b32 s18, s18
    v_readlane_b32 s17, v11, s18
    s_bitset0_b32 m0, 16
    s_add_u32 s15, s15, 1
    s_cmp_eq_u32 s15, 128
    s_cbranch_scc1 L_wrap
    s_cmp_eq_u32 s15, 255
    s_cbranch_scc1 L_last
L_disp:
    s_cmp_eq_u32 s16, 3
    s_cbranch_scc1 L_ld3
    s_cmp_eq_u32 s16, 2
    s_cbranch_scc1 L_ld2
    s_cmp_eq_u32 s16, 4
    s_cbranch_scc1 L_ld4
    s_cmp_eq_u32 s16, 1
    s_cbranch_scc1 L_ld1
    s_cmp_eq_u32 s16, 5
    s_cbranch_scc1 L_ld5
    s_cmp_eq_u32 s16, 0
    s_cbranch_scc1 L_ld0
    s_cmp_eq_u32 s16, 6
    s_cbranch_scc1 L_ld6
    s_branch L_ld7
L_tab:
    s_mov_b32 s18, 0x2df00
    v_writelane_b32 v11, s18, 2
    s_mov_b32 s18, 0x75600
    v_writelane_b32 v11, s18, 3
    s_mov_b32 s18, 0x2f500
    v_writelane_b32 v11, s18, 4
    s_mov_b32 s18, 0x65000
    v_writelane_b32 v11, s18, 5
    s_mov_b32 s18, 0x61000
    v_writelane_b32 v11, s18, 6
    s_mov_b32 s18, 0x61000
    v_writelane_b32 v11, s18, 7
    s_branch L_nb
L_wrap:
    s_add_u32 s8, s28, s12
    s_addc_u32 s9, s29, 0
    s_branch L_disp
L_ld0:
    s_waitcnt vmcnt(18)
    buffer_load_dwordx4 v1, s[8:11], 0 offen nt lds
    s_addk_i32 m0, 1024
    v_xor_b32 v1, s17, v1
    s_barrier
    s_waitcnt vmcnt(18)
    buffer_load_dwordx4 v2, s[8:11], 0 offen nt lds
    s_addk_i32 m0, 1024
    v_xor_b32 v2, s17, v2
    s_waitcnt vmcnt(18)
    buffer_load_dwordx4 v3, s[8:11], 0 offen nt lds
    s_addk_i32 m0, 1024
    v_xor_b32 v3, s17, v3
    ds_read_b32 v10, v9
    s_waitcnt vmcnt(18)
    buffer_load_dwordx4 v4, s[8:11], 0 offen nt lds
    s_addk_i32 m0, 1024
    v_xor_b32 v4, s17, v4
    s_waitcnt vmcnt(18)
    buffer_load_dwordx4 v5, s[8:11], 0 offen nt lds
    s_addk_i32 m0, 1024
    v_xor_b32 v5, s17, v5
    s_waitcnt vmcnt(18)
    buffer_load_dwordx4 v6, s[8:11], 0 offen nt lds
    s_addk_i32 m0, 1024
    v_xor_b32 v6, s17, v6
    s_waitcnt vmcnt(18)
    buffer_load_dwordx4 v7, s[8:11], 0 offen nt lds
    s_addk_i32 m0, 1024
    v_xor_b32 v7, s17, v7
    s_waitcnt vmcnt(18)
    buffer_load_dwordx4 v8, s[8:11], 0 offen nt lds
    s_addk_i32 m0, 1024
    v_xor_b32 v8, s17, v8
    s_branch L_next
L_ld1:
    s_waitcnt vmcnt(19)
    buffer_load_dwordx4 v1, s[8:11], 0 offen nt lds
    s_addk_i32 m0, 1024
    v_xor_b32 v1, s17, v1
    s_barrier
    s_waitcnt vmcnt(19)
    buffer_load_dwordx4 v2, s[8:11], 0 offen nt lds
    s_addk_i32 m0, 1024
    v_xor_b32 v2, s17, v2
    s_waitcnt vmcnt(19)
    buffer_load_dwordx4 v3, s[8:11], 0 offen nt lds
    s_addk_i32 m0, 1024
    v_xor_b32 v3, s17, v3
    ds_read_b32 v10, v9
    s_waitcnt vmcnt(19)
    buffer_load_dwordx4 v4, s[8:11], 0 offen nt lds
    s_addk_i32 m0, 1024
    v_xor_b32 v4, s17, v4
    s_waitcnt vmcnt(19)
    buffer_load_dwordx4 v5, s[8:11], 0 offen nt lds
    s_addk_i32 m0, 1024
    v_xor_b32 v5, s17, v5
    s_waitcnt vmcnt(19)
    buffer_load_dwordx4 v6, s[8:11], 0 offen nt lds
    s_addk_i32 m0, 1024
    v_xor_b32 v6, s17, v6
    s_waitcnt vmcnt(19)
    buffer_load_dwordx4 v7, s[8:11], 0 offen nt lds
    s_addk_i32 m0, 1024
    v_xor_b32 v7, s17, v7
    s_waitcnt vmcnt(19)
    buffer_load_dwordx4 v8, s[8:11], 0 offen nt lds
    s_addk_i32 m0, 1024
    v_xor_b32 v8, s17, v8
    s_branch L_next
L_ld2:
    s_waitcnt vmcnt(20)
    buffer_load_dwordx4 v1, s[8:11], 0 offen nt lds
    s_addk_i32 m0, 1024
    v_xor_b32 v1, s17, v1
    s_barrier
    s_waitcnt vmcnt(20)
    buffer_load_dwordx4 v2, s[8:11], 0 offen nt lds
    s_addk_i32 m0, 1024
    v_xor_b32 v2, s17, v2
    s_waitcnt vmcnt(20)
    buffer_load_dwordx4 v3, s[8:11], 0 offen nt lds
    s_addk_i32 m0, 1024
    v_xor_b32 v3, s17, v3
    ds_read_b32 v10, v9
    s_waitcnt vmcnt(20)
    buffer_load_dwordx4 v4, s[8:11], 0 offen nt lds
    s_addk_i32 m0, 1024
    v_xor_b32 v4, s17, v4
    s_waitcnt vmcnt(20)
    buffer_load_dwordx4 v5, s[8:11], 0 offen nt lds
    s_addk_i32 m0, 1024
    v_xor_b32 v5, s17, v5
    s_waitcnt vmcnt(20)
    buffer_load_dwordx4 v6, s[8:11], 0 offen nt lds
    s_addk_i32 m0, 1024
    v_xor_b32 v6, s17, v6
    s_waitcnt vmcnt(20)
    buffer_load_dwordx4 v7, s[8:11], 0 offen nt lds
    s_addk_i32 m0, 1024
    v_xor_b32 v7, s17, v7
    s_waitcnt vmcnt(20)
    buffer_load_dwordx4 v8, s[8:11], 0 offen nt lds
    s_addk_i32 m0, 1024
    v_xor_b32 v8, s17, v8
    s_branch L_next
L_ld4:
    s_waitcnt vmcnt(22)
    buffer_load_dwordx4 v1, s[8:11], 0 offen nt lds
    s_addk_i32 m0, 1024
    v_xor_b32 v1, s17, v1
    s_barrier
    s_waitcnt vmcnt(22)
    buffer_load_dwordx4 v2, s[8:11], 0 offen nt lds
    s_addk_i32 m0, 1024
    v_xor_b32 v2, s17, v2
    s_waitcnt vmcnt(22)
    buffer_load_dwordx4 v3, s[8:11], 0 offen nt lds
    s_addk_i32 m0, 1024
    v_xor_b32 v3, s17, v3
    ds_read_b32 v10, v9
    s_waitcnt vmcnt(22)
    buffer_load_dwordx4 v4, s[8:11], 0 offen nt lds
    s_addk_i32 m0, 1024
    v_xor_b32 v4, s17, v4
    s_waitcnt vmcnt(22)
    buffer_load_dwordx4 v5, s[8:11], 0 offen nt lds
    s_addk_i32 m0, 1024
    v_xor_b32 v5, s17, v5
    s_waitcnt vmcnt(22)
    buffer_load_dwordx4 v6, s[8:11], 0 offen nt lds
    s_addk_i32 m0, 1024
    v_xor_b32 v6, s17, v6
    s_waitcnt vmcnt(22)
    buffer_load_dwordx4 v7, s[8:11], 0 offen nt lds
    s_addk_i32 m0, 1024
    v_xor_b32 v7, s17, v7
    s_waitcnt vmcnt(22)
    buffer_load_dwordx4 v8, s[8:11], 0 offen nt lds
    s_addk_i32 m0, 1024
    v_xor_b32 v8, s17, v8
    s_branch L_next
L_ld5:
    s_waitcnt vmcnt(23)
    buffer_load_dwordx4 v1, s[8:11], 0 offen nt lds
    s_addk_i32 m0, 1024
    v_xor_b32 v1, s17, v1
    s_barrier
    s_waitcnt vmcnt(23)
    buffer_load_dwordx4 v2, s[8:11], 0 offen nt lds
    s_addk_i32 m0, 1024
    v_xor_b32 v2, s17, v2
    s_waitcnt vmcnt(23)
    buffer_load_dwordx4 v3, s[8:11], 0 offen nt lds
    s_addk_i32 m0, 1024
    v_xor_b32 v3, s17, v3
    ds_read_b32 v10, v9
    s_waitcnt vmcnt(23)
    buffer_load_dwordx4 v4, s[8:11], 0 offen nt lds
    s_addk_i32 m0, 1024
    v_xor_b32 v4, s17, v4
    s_waitcnt vmcnt(23)
    buffer_load_dwordx4 v5, s[8:11], 0 offen nt lds
    s_addk_i32 m0, 1024
    v_xor_b32 v5, s17, v5
    s_waitcnt vmcnt(23)
    buffer_load_dwordx4 v6, s[8:11], 0 offen nt lds
    s_addk_i32 m0, 1024
    v_xor_b32 v6, s17, v6
    s_waitcnt vmcnt(23)
    buffer_load_dwordx4 v7, s[8:11], 0 offen nt lds
    s_addk_i32 m0, 1024
    v_xor_b32 v7, s17, v7
    s_waitcnt vmcnt(23)
    buffer_load_dwordx4 v8, s[8:11], 0 offen nt lds
    s_addk_i32 m0, 1024
    v_xor_b32 v8, s17, v8
    s_branch L_next
L_ld6:
    s_waitcnt vmcnt(24)
    buffer_load_dwordx4 v1, s[8:11], 0 offen nt lds
    s_addk_i32 m0, 1024
    v_xor_b32 v1, s17, v1
    s_barrier
    s_waitcnt vmcnt(24)
    buffer_load_dwordx4 v2, s[8:11], 0 offen nt lds
    s_addk_i32 m0, 1024
    v_xor_b32 v2, s17, v2
    s_waitcnt vmcnt(24)
    buffer_load_dwordx4 v3, s[8:11], 0 offen nt lds
    s_addk_i32 m0, 1024
    v_xor_b32 v3, s17, v3
    ds_read_b32 v10, v9
    s_waitcnt vmcnt(24)
    buffer_load_dwordx4 v4, s[8:11], 0 offen nt lds
    s_addk_i32 m0, 1024
    v_xor_b32 v4, s17, v4
    s_waitcnt vmcnt(24)
    buffer_load_dwordx4 v5, s[8:11], 0 offen nt lds
    s_addk_i32 m0, 1024
    v_xor_b32 v5, s17, v5
    s_waitcnt vmcnt(24)
    buffer_load_dwordx4 v6, s[8:11], 0 offen nt lds
    s_addk_i32 m0, 1024
    v_xor_b32 v6, s17, v6
    s_waitcnt vmcnt(24)
    buffer_load_dwordx4 v7, s[8:11], 0 offen nt lds
    s_addk_i32 m0, 1024
    v_xor_b32 v7, s17, v7
    s_waitcnt vmcnt(24)
    buffer_load_dwordx4 v8, s[8:11], 0 offen nt lds
    s_addk_i32 m0, 1024
    v_xor_b32 v8, s17, v8
    s_branch L_next
L_ld7:
    s_waitcnt vmcnt(25)
    buffer_load_dwordx4 v1, s[8:11], 0 offen nt lds
    s_addk_i32 m0, 1024
    v_xor_b32 v1, s17, v1
    s_waitcnt vmcnt(25)
    buffer_load_dwordx4 v2, s[8:11], 0 offen nt lds
    s_addk_i32 m0, 1024
    v_xor_b32 v2, s17, v2
    s_barrier
    s_waitcnt vmcnt(25)
    buffer_load_dwordx4 v3, s[8:11], 0 offen nt lds
    s_addk_i32 m0, 1024
    v_xor_b32 v3, s17, v3
    ds_read_b32 v10, v9
    s_waitcnt vmcnt(25)
    buffer_load_dwordx4 v4, s[8:11], 0 offen nt lds
    s_addk_i32 m0, 1024
    v_xor_b32 v4, s17, v4
    s_waitcnt vmcnt(25)
    buffer_load_dwordx4 v5, s[8:11], 0 offen nt lds
    s_addk_i32 m0, 1024
    v_xor_b32 v5, s17, v5
    s_waitcnt vmcnt(25)
    buffer_load_dwordx4 v6, s[8:11], 0 offen nt lds
    s_addk_i32 m0, 1024
    v_xor_b32 v6, s17, v6
    s_waitcnt vmcnt(25)
    buffer_load_dwordx4 v7, s[8:11], 0 offen nt lds
    s_addk_i32 m0, 1024
    v_xor_b32 v7, s17, v7
    s_waitcnt vmcnt(25)
    buffer_load_dwordx4 v8, s[8:11], 0 offen nt lds
    s_addk_i32 m0, 1024
    v_xor_b32 v8, s17, v8
    s_branch L_next
L_last:
    s_waitcnt vmcnt(24)
    s_barrier
    s_waitcnt vmcnt(16)
    s_barrier
    s_waitcnt vmcnt(8)
    s_barrier
    s_waitcnt vmcnt(0)
    s_barrier
    s_endpgm
.p2align 12
L_ctrl:
    s_load_dwordx2 s[8:9], s[0:1], 40
    s_bitcmp1_b32 s2, 0
    s_cselect_b32 s12, 0x9500, 0
    s_bitcmp1_b32 s2, 1
    s_cselect_b32 s13, 0xc000, 0
    s_xor_b32 s12, s12, s13
    s_bitcmp1_b32 s2, 2
    s_cselect_b32 s13, 0x9400, 0
    s_xor_b32 s12, s12, s13
    s_bitcmp1_b32 s2, 3
    s_cselect_b32 s13, 0xca00, 0
    s_xor_b32 s12, s12, s13
    s_bitcmp1_b32 s2, 4
    s_cselect_b32 s13, 0x1b00, 0
    s_xor_b32 s12, s12, s13
    s_bitcmp1_b32 s2, 5
    s_cselect_b32 s13, 0xa000, 0
    s_xor_b32 s12, s12, s13
    s_bitcmp1_b32 s2, 6
    s_cselect_b32 s13, 0x5600, 0
    s_xor_b32 s12, s12, s13
    s_bitcmp1_b32 s2, 7
    s_cselect_b32 s13, 0x8900, 0
    s_xor_b32 s12, s12, s13
    s_lshl_b32 s12, s12, 12
    v_mov_b32 v15, s12
    s_lshr_b32 s21, s2, 2
    s_add_u32 s21, s21, 32
    s_getreg_b32 s10, hwreg(HW_REG_XCC_ID,0,3)
    s_lshl_b32 s10, s10, 8
    v_and_b32 v0, 63, v0
    v_add_u32 v1, s10, v0
    s_lshr_b32 s11, s2, 3
    s_add_u32 s10, s10, s11
    v_mov_b32 v2, s10
    s_lshl_b32 s16, s11, 8
    s_add_u32 s16, s16, 4096
    v_mov_b32 v6, s16
    s_lshl_b32 s16, s11, 3
    s_add_u32 s16, s16, 8
    s_cmp_gt_u32 s16, 236
    s_cselect_b32 s16, 0x1000, s16
    s_add_u32 s17, s16, 6
    s_and_b32 s11, s11, 7
    s_add_u32 s11, s11, 16
    s_add_u32 s12, s11, 3
    s_mov_b32 s13, 0
    v_mov_b32 v3, 0
    v_mov_b32 v9, 1
    v_mov_b32 v5, 81952
    v_lshlrev_b32 v10, 3, v0
    v_add_u32 v10, -224, v10
    v_mov_b32 v11, 3
    v_mov_b32 v12, 78
    s_waitcnt lgkmcnt(0)
    global_store_byte v1, v3, s[8:9]
    s_mov_b64 exec, 1
    global_load_dword v8, v6, s[8:9] sc1
L_cl:
    s_barrier
    global_store_byte v2, v3, s[8:9]
    s_cmp_eq_u32 s13, s16
    s_cbranch_scc0 L_c0
    global_atomic_add v7, v6, v9, s[8:9] sc0
L_c0:
    s_cmp_eq_u32 s13, s17
    s_cbranch_scc0 L_c1
    s_waitcnt vmcnt(6)
    v_sub_u32 v7, v7, v8
    v_min_u32 v7, 7, v7
    v_lshl_add_u32 v7, v7, 1, 1
    global_store_byte v2, v7, s[8:9] offset:32
L_c1:
    s_cmp_eq_u32 s13, s21
    s_cbranch_scc0 L_c1b
    global_load_dword v15, v15, s[28:29] nt
L_c1b:
    s_cmp_eq_u32 s13, s11
    s_cbranch_scc0 L_c2
    s_mov_b64 exec, -1
    global_load_ubyte v4, v1, s[8:9] sc1
    s_mov_b64 exec, 1
    s_add_u32 s11, s11, 8
L_c2:
    s_cmp_eq_u32 s13, s12
    s_cbranch_scc0 L_c3
    s_sub_u32 s14, s13, 3
    s_add_u32 s12, s12, 8
    s_mov_b64 exec, -1
    v_cmp_lt_i32 vcc, s14, v10
    v_mov_b32 v13, 8
    s_nop 0
    v_cndmask_b32 v14, v11, v12, vcc
    s_mov_b32 exec_hi, 0
    v_mov_b32 v13, s14
    v_mov_b32 v14, 50
    s_mov_b32 exec_hi, -1
    s_waitcnt vmcnt(3)
    v_cmp_ne_u32 vcc, 0, v4
    v_sub_u32 v4, v4, v13
    v_mul_i32_i24 v4, v4, v14
    v_cndmask_b32 v4, 0, v4, vcc
    s_nop 1
    v_add_u32_dpp v4, v4, v4 row_ror:8 row_mask:0xf bank_mask:0xf
    s_nop 1
    v_add_u32_dpp v4, v4, v4 row_ror:4 row_mask:0xf bank_mask:0xf
    s_nop 1
    v_add_u32_dpp v4, v4, v4 row_ror:2 row_mask:0xf bank_mask:0xf
    s_nop 1
    v_add_u32_dpp v4, v4, v4 row_ror:1 row_mask:0xf bank_mask:0xf
    s_nop 0
    v_readlane_b32 s14, v4, 0
    v_readlane_b32 s15, v4, 16
    v_readlane_b32 s18, v4, 32
    v_readlane_b32 s19, v4, 48
    s_mov_b64 exec, 1
    s_add_u32 s14, s14, s15
    s_add_u32 s18, s18, s19
    s_add_u32 s14, s14, s18
    s_add_i32 s14, s14, 4228
    s_ashr_i32 s14, s14, 10
    s_max_i32 s14, s14, 0
    s_min_i32 s14, s14, 7
    v_mov_b32 v4, s14
    ds_write_b32 v5, v4
L_c3:
    s_add_u32 s13, s13, 1
    v_mov_b32 v3, s13
    s_cmp_lt_u32 s13, 248
    s_cbranch_scc1 L_cl
    s_barrier
    s_barrier
    s_barrier
    s_barrier
    s_endpgm
L_cons:
    s_bitcmp1_b32 s2, 0
    s_cselect_b32 s12, 0x9586400, 0
    s_bitcmp1_b32 s2, 1
    s_cselect_b32 s13, 0xc0ca300, 0
    s_xor_b32 s12, s12, s13
    s_bitcmp1_b32 s2, 2
    s_cselect_b32 s13, 0x9424200, 0
    s_xor_b32 s12, s12, s13
    s_bitcmp1_b32 s2, 3
    s_cselect_b32 s13, 0xca8d900, 0
    s_xor_b32 s12, s12, s13
    s_bitcmp1_b32 s2, 4
    s_cselect_b32 s13, 0x1baa700, 0
    s_xor_b32 s12, s12, s13
    s_bitcmp1_b32 s2, 5
    s_cselect_b32 s13, 0xa0e1400, 0
    s_xor_b32 s12, s12, s13
    s_bitcmp1_b32 s2, 6
    s_cselect_b32 s13, 0x5666000, 0
    s_xor_b32 s12, s12, s13
    s_bitcmp1_b32 s2, 7
    s_cselect_b32 s13, 0x8917900, 0
    s_xor_b32 s12, s12, s13
    s_lshr_b32 s13, s12, 20
    s_lshl_b32 s13, s13, 8
    v_and_b32 v1, 15, v0
    v_lshl_or_b32 v54, v1, 4, s12
    v_lshl_add_u32 v1, v1, 4, s13
    s_waitcnt lgkmcnt(0)
    global_load_dwordx4 v[4:7], v1, s[24:25]
    v_subrev_u32 v0, 64, v0
    v_bfe_u32 v2, v0, 4, 2
    v_lshl_add_u32 v1, v2, 2, v1
    v_bfe_i32 v2, v0, 4, 1
    v_and_b32 v2, 0x17900, v2
    v_xor_b32 v54, v54, v2
    v_bfe_i32 v2, v0, 5, 1
    v_and_b32 v2, 0x89000, v2
    v_xor_b32 v54, v54, v2
    v_bfe_i32 v2, v0, 6, 1
    v_and_b32 v2, 0x95b00, v2
    v_xor_b32 v54, v54, v2
    v_bfe_i32 v2, v0, 7, 1
    v_and_b32 v2, 0xd5a00, v2
    v_xor_b32 v54, v54, v2
    v_xor_b32 v54, 0x61000, v54
    v_xor_b32 v55, 0x8100, v54
    v_lshrrev_b32 v3, 6, v0
    v_lshlrev_b32 v36, 4, v0
    v_lshrrev_b32 v37, 3, v0
    v_lshlrev_b32 v37, 2, v37
    v_add_u32 v37, 65536, v37
    v_mov_b32 v34, 0xff7fffff
    v_mov_b32 v35, 0
    v_mov_b32 v24, 0
    v_mov_b32 v25, 0
    v_mov_b32 v26, 0
    v_mov_b32 v27, 0
    v_mov_b32 v28, 0
    v_mov_b32 v29, 0
    v_mov_b32 v30, 0
    v_mov_b32 v31, 0
    s_mov_b32 s20, 0x3fb8aa3b
    s_mov_b32 s23, 0x3db504f3
    s_mov_b32 s21, 0xffff
    s_barrier
    ds_read_b128 v[8:11], v36
    ds_read_b128 v[12:15], v36 offset:4096
    v_add_u32 v36, 0x2000, v36
    v_and_b32 v36, s21, v36
    s_mov_b32 s22, 64
    s_waitcnt vmcnt(0) lgkmcnt(0)
L_k:
    s_barrier
    ds_read_b128 v[16:19], v36
    ds_read_b128 v[20:23], v36 offset:4096
    v_add_u32 v36, 0x2000, v36
    v_and_b32 v36, s21, v36
    s_waitcnt lgkmcnt(2)
    v_dot2_f32_bf16 v32, v8, v4, 0
    v_dot2_f32_bf16 v33, v12, v4, 0
    v_dot2_f32_bf16 v32, v9, v5, v32
    v_dot2_f32_bf16 v33, v13, v5, v33
    v_dot2_f32_bf16 v32, v10, v6, v32
    v_dot2_f32_bf16 v33, v14, v6, v33
    v_dot2_f32_bf16 v32, v11, v7, v32
    v_dot2_f32_bf16 v33, v15, v7, v33
    s_nop 1
    v_add_f32_dpp v32, v32, v32 row_ror:8 row_mask:0xf bank_mask:0x3
    s_nop 1
    v_add_f32_dpp v32, v33, v33 row_ror:8 row_mask:0xf bank_mask:0xc
    s_nop 1
    v_add_f32_dpp v32, v32, v32 row_half_mirror row_mask:0xf bank_mask:0xf
    s_nop 1
    v_add_f32_dpp v32, v32, v32 quad_perm:[2,3,0,1] row_mask:0xf bank_mask:0xf
    s_nop 1
    v_add_f32_dpp v32, v32, v32 quad_perm:[1,0,3,2] row_mask:0xf bank_mask:0xf
    v_cvt_pk_bf16_f32 v32, 0, v32
    v_mul_f32 v32, s23, v32
    v_cvt_pk_bf16_f32 v32, 0, v32
    ds_write_b32 v37, v32
    v_sub_f32 v38, v32, v34
    v_max_f32 v34, v34, v32
    v_cmp_lt_f32 vcc, 0, v38
    v_mul_f32 v38, s20, -|v38|
    v_exp_f32 v38, v38
    v_add_u32 v37, 128, v37
    v_fma_f32 v39, v35, v38, 1.0
    v_add_f32 v35, v35, v38
    v_cndmask_b32 v35, v35, v39, vcc
    s_barrier
    ds_read_b128 v[8:11], v36
    ds_read_b128 v[12:15], v36 offset:4096
    v_add_u32 v36, 0x2000, v36
    v_and_b32 v36, s21, v36
    s_waitcnt lgkmcnt(2)
    v_dot2_f32_bf16 v32, v16, v4, 0
    v_dot2_f32_bf16 v33, v20, v4, 0
    v_dot2_f32_bf16 v32, v17, v5, v32
    v_dot2_f32_bf16 v33, v21, v5, v33
    v_dot2_f32_bf16 v32, v18, v6, v32
    v_dot2_f32_bf16 v33, v22, v6, v33
    v_dot2_f32_bf16 v32, v19, v7, v32
    v_dot2_f32_bf16 v33, v23, v7, v33
    s_nop 1
    v_add_f32_dpp v32, v32, v32 row_ror:8 row_mask:0xf bank_mask:0x3
    s_nop 1
    v_add_f32_dpp v32, v33, v33 row_ror:8 row_mask:0xf bank_mask:0xc
    s_nop 1
    v_add_f32_dpp v32, v32, v32 row_half_mirror row_mask:0xf bank_mask:0xf
    s_nop 1
    v_add_f32_dpp v32, v32, v32 quad_perm:[2,3,0,1] row_mask:0xf bank_mask:0xf
    s_nop 1
    v_add_f32_dpp v32, v32, v32 quad_perm:[1,0,3,2] row_mask:0xf bank_mask:0xf
    v_cvt_pk_bf16_f32 v32, 0, v32
    v_mul_f32 v32, s23, v32
    v_cvt_pk_bf16_f32 v32, 0, v32
    ds_write_b32 v37, v32
    v_sub_f32 v38, v32, v34
    v_max_f32 v34, v34, v32
    v_cmp_lt_f32 vcc, 0, v38
    v_mul_f32 v38, s20, -|v38|
    v_exp_f32 v38, v38
    v_add_u32 v37, 128, v37
    v_fma_f32 v39, v35, v38, 1.0
    v_add_f32 v35, v35, v38
    v_cndmask_b32 v35, v35, v39, vcc
    s_sub_u32 s22, s22, 1
    s_cmp_lg_u32 s22, 0
    s_cbranch_scc1 L_k
    s_mov_b32 s22, 81920
    v_mov_b32 v32, v34
    v_max_f32_dpp v34, v34, v34 row_ror:8 row_mask:0xf bank_mask:0xf
    v_lshl_add_u32 v39, v3, 2, s22
    v_mov_b32 v38, v34
    s_nop 1
    v_permlane32_swap_b32 v34, v38
    s_nop 1
    v_max_f32 v34, v34, v38
    v_mov_b32 v38, v34
    s_nop 1
    v_permlane16_swap_b32 v34, v38
    s_nop 1
    v_max_f32 v34, v34, v38
    ds_write_b32 v39, v34 offset:0
    v_sub_f32 v32, v32, v34
    v_mul_f32 v32, s20, v32
    v_exp_f32 v32, v32
    v_subrev_u32 v37, 0x4000, v37
    v_mul_f32 v35, v35, v32
    ds_read_b32 v46, v37 offset:15872
    ds_read_b32 v48, v37 offset:16000
    ds_read_b32 v50, v37 offset:16128
    ds_read_b32 v52, v37 offset:16256
    v_add_f32_dpp v35, v35, v35 row_ror:8 row_mask:0xf bank_mask:0xf
    v_lshl_add_u32 v39, v3, 2, s22
    v_mov_b32 v38, v35
    s_nop 1
    v_permlane32_swap_b32 v35, v38
    s_nop 1
    v_add_f32 v35, v35, v38
    v_mov_b32 v38, v35
    s_nop 1
    v_permlane16_swap_b32 v35, v38
    s_nop 1
    v_add_f32 v35, v35, v38
    ds_write_b32 v39, v35 offset:16
    v_mov_b32 v39, s22
    ds_read_b32 v44, v37
    v_add_u32 v37, 128, v37
    ds_read_b32 v42, v37
    v_add_u32 v37, 128, v37
    s_mov_b32 s22, 61
    s_waitcnt lgkmcnt(0)
    s_barrier
    ds_read_b128 v[4:7], v39
    ds_read_b128 v[16:19], v39 offset:16
    s_waitcnt lgkmcnt(1)
    v_max3_f32 v34, v4, v5, v6
    v_max_f32 v34, v34, v7
    v_sub_f32 v4, v4, v34
    v_mul_f32 v4, s20, v4
    v_exp_f32 v4, v4
    v_sub_f32 v5, v5, v34
    v_mul_f32 v5, s20, v5
    v_exp_f32 v5, v5
    v_sub_f32 v6, v6, v34
    v_mul_f32 v6, s20, v6
    v_exp_f32 v6, v6
    v_sub_f32 v7, v7, v34
    v_mul_f32 v7, s20, v7
    v_exp_f32 v7, v7
    s_waitcnt lgkmcnt(0)
    v_mul_f32 v35, v16, v4
    v_fmac_f32 v35, v17, v5
    v_fmac_f32 v35, v18, v6
    v_fmac_f32 v35, v19, v7
    v_log_f32 v43, v35
    v_sub_f32 v46, v46, v34
    v_fma_f32 v46, v46, s20, -v43
    v_sub_f32 v48, v48, v34
    v_fma_f32 v48, v48, s20, -v43
    v_sub_f32 v50, v50, v34
    v_fma_f32 v50, v50, s20, -v43
    v_sub_f32 v52, v52, v34
    v_fma_f32 v52, v52, s20, -v43
    v_exp_f32 v46, v46
    v_exp_f32 v48, v48
    v_exp_f32 v50, v50
    v_exp_f32 v52, v52
    v_sub_f32 v38, v44, v34
    v_fma_f32 v38, v38, s20, -v43
    v_exp_f32 v38, v38
    s_nop 0
    v_cvt_pk_bf16_f32 v40, 0, v38
    v_cvt_pk_bf16_f32 v41, v38, 0
    v_cvt_pk_bf16_f32 v47, v46, 0
    v_cvt_pk_bf16_f32 v46, 0, v46
    v_cvt_pk_bf16_f32 v49, v48, 0
    v_cvt_pk_bf16_f32 v48, 0, v48
    v_cvt_pk_bf16_f32 v51, v50, 0
    v_cvt_pk_bf16_f32 v50, 0, v50
    v_cvt_pk_bf16_f32 v53, v52, 0
    v_cvt_pk_bf16_f32 v52, 0, v52
    s_branch L_v0
L_v:
    s_barrier
L_v0:
    ds_read_b128 v[16:19], v36
    ds_read_b128 v[20:23], v36 offset:4096
    v_add_u32 v36, 0x2000, v36
    v_and_b32 v36, s21, v36
    ds_read_b32 v44, v37
    v_add_u32 v37, 128, v37
    s_waitcnt lgkmcnt(3)
    v_sub_f32 v38, v42, v34
    v_fma_f32 v38, v38, s20, -v43
    v_exp_f32 v38, v38
    v_dot2c_f32_bf16_dpp v25, v40, v8 row_newbcast:0 row_mask:0xf bank_mask:0xf
    v_dot2c_f32_bf16_dpp v24, v41, v8 row_newbcast:0 row_mask:0xf bank_mask:0xf
    v_dot2c_f32_bf16_dpp v27, v40, v9 row_newbcast:0 row_mask:0xf bank_mask:0xf
    v_dot2c_f32_bf16_dpp v26, v41, v9 row_newbcast:0 row_mask:0xf bank_mask:0xf
    v_dot2c_f32_bf16_dpp v29, v40, v10 row_newbcast:0 row_mask:0xf bank_mask:0xf
    v_dot2c_f32_bf16_dpp v28, v41, v10 row_newbcast:0 row_mask:0xf bank_mask:0xf
    v_dot2c_f32_bf16_dpp v31, v40, v11 row_newbcast:0 row_mask:0xf bank_mask:0xf
    v_dot2c_f32_bf16_dpp v30, v41, v11 row_newbcast:0 row_mask:0xf bank_mask:0xf
    v_dot2c_f32_bf16_dpp v25, v40, v12 row_newbcast:8 row_mask:0xf bank_mask:0xf
    v_dot2c_f32_bf16_dpp v24, v41, v12 row_newbcast:8 row_mask:0xf bank_mask:0xf
    v_dot2c_f32_bf16_dpp v27, v40, v13 row_newbcast:8 row_mask:0xf bank_mask:0xf
    v_dot2c_f32_bf16_dpp v26, v41, v13 row_newbcast:8 row_mask:0xf bank_mask:0xf
    v_dot2c_f32_bf16_dpp v29, v40, v14 row_newbcast:8 row_mask:0xf bank_mask:0xf
    v_dot2c_f32_bf16_dpp v28, v41, v14 row_newbcast:8 row_mask:0xf bank_mask:0xf
    v_dot2c_f32_bf16_dpp v31, v40, v15 row_newbcast:8 row_mask:0xf bank_mask:0xf
    v_dot2c_f32_bf16_dpp v30, v41, v15 row_newbcast:8 row_mask:0xf bank_mask:0xf
    v_cvt_pk_bf16_f32 v40, 0, v38
    v_cvt_pk_bf16_f32 v41, v38, 0
    s_barrier
    ds_read_b128 v[8:11], v36
    ds_read_b128 v[12:15], v36 offset:4096
    v_add_u32 v36, 0x2000, v36
    v_and_b32 v36, s21, v36
    ds_read_b32 v42, v37
    v_add_u32 v37, 128, v37
    s_waitcnt lgkmcnt(3)
    v_sub_f32 v38, v44, v34
    v_fma_f32 v38, v38, s20, -v43
    v_exp_f32 v38, v38
    v_dot2c_f32_bf16_dpp v25, v40, v16 row_newbcast:0 row_mask:0xf bank_mask:0xf
    v_dot2c_f32_bf16_dpp v24, v41, v16 row_newbcast:0 row_mask:0xf bank_mask:0xf
    v_dot2c_f32_bf16_dpp v27, v40, v17 row_newbcast:0 row_mask:0xf bank_mask:0xf
    v_dot2c_f32_bf16_dpp v26, v41, v17 row_newbcast:0 row_mask:0xf bank_mask:0xf
    v_dot2c_f32_bf16_dpp v29, v40, v18 row_newbcast:0 row_mask:0xf bank_mask:0xf
    v_dot2c_f32_bf16_dpp v28, v41, v18 row_newbcast:0 row_mask:0xf bank_mask:0xf
    v_dot2c_f32_bf16_dpp v31, v40, v19 row_newbcast:0 row_mask:0xf bank_mask:0xf
    v_dot2c_f32_bf16_dpp v30, v41, v19 row_newbcast:0 row_mask:0xf bank_mask:0xf
    v_dot2c_f32_bf16_dpp v25, v40, v20 row_newbcast:8 row_mask:0xf bank_mask:0xf
    v_dot2c_f32_bf16_dpp v24, v41, v20 row_newbcast:8 row_mask:0xf bank_mask:0xf
    v_dot2c_f32_bf16_dpp v27, v40, v21 row_newbcast:8 row_mask:0xf bank_mask:0xf
    v_dot2c_f32_bf16_dpp v26, v41, v21 row_newbcast:8 row_mask:0xf bank_mask:0xf
    v_dot2c_f32_bf16_dpp v29, v40, v22 row_newbcast:8 row_mask:0xf bank_mask:0xf
    v_dot2c_f32_bf16_dpp v28, v41, v22 row_newbcast:8 row_mask:0xf bank_mask:0xf
    v_dot2c_f32_bf16_dpp v31, v40, v23 row_newbcast:8 row_mask:0xf bank_mask:0xf
    v_dot2c_f32_bf16_dpp v30, v41, v23 row_newbcast:8 row_mask:0xf bank_mask:0xf
    v_cvt_pk_bf16_f32 v40, 0, v38
    v_cvt_pk_bf16_f32 v41, v38, 0
    s_sub_u32 s22, s22, 1
    s_cmp_lg_u32 s22, 0
    s_cbranch_scc1 L_v
    s_barrier
    global_load_dwordx4 v[56:59], v54, s[28:29] nt
    global_load_dwordx4 v[60:63], v55, s[28:29] nt
    ds_read_b128 v[16:19], v36 offset:0
    ds_read_b128 v[20:23], v36 offset:4096
    s_waitcnt lgkmcnt(2)
    v_sub_f32 v38, v42, v34
    v_fma_f32 v38, v38, s20, -v43
    v_exp_f32 v38, v38
    v_dot2c_f32_bf16_dpp v25, v40, v8 row_newbcast:0 row_mask:0xf bank_mask:0xf
    v_dot2c_f32_bf16_dpp v24, v41, v8 row_newbcast:0 row_mask:0xf bank_mask:0xf
    v_dot2c_f32_bf16_dpp v27, v40, v9 row_newbcast:0 row_mask:0xf bank_mask:0xf
    v_dot2c_f32_bf16_dpp v26, v41, v9 row_newbcast:0 row_mask:0xf bank_mask:0xf
    v_dot2c_f32_bf16_dpp v29, v40, v10 row_newbcast:0 row_mask:0xf bank_mask:0xf
    v_dot2c_f32_bf16_dpp v28, v41, v10 row_newbcast:0 row_mask:0xf bank_mask:0xf
    v_dot2c_f32_bf16_dpp v31, v40, v11 row_newbcast:0 row_mask:0xf bank_mask:0xf
    v_dot2c_f32_bf16_dpp v30, v41, v11 row_newbcast:0 row_mask:0xf bank_mask:0xf
    v_dot2c_f32_bf16_dpp v25, v40, v12 row_newbcast:8 row_mask:0xf bank_mask:0xf
    v_dot2c_f32_bf16_dpp v24, v41, v12 row_newbcast:8 row_mask:0xf bank_mask:0xf
    v_dot2c_f32_bf16_dpp v27, v40, v13 row_newbcast:8 row_mask:0xf bank_mask:0xf
    v_dot2c_f32_bf16_dpp v26, v41, v13 row_newbcast:8 row_mask:0xf bank_mask:0xf
    v_dot2c_f32_bf16_dpp v29, v40, v14 row_newbcast:8 row_mask:0xf bank_mask:0xf
    v_dot2c_f32_bf16_dpp v28, v41, v14 row_newbcast:8 row_mask:0xf bank_mask:0xf
    v_dot2c_f32_bf16_dpp v31, v40, v15 row_newbcast:8 row_mask:0xf bank_mask:0xf
    v_dot2c_f32_bf16_dpp v30, v41, v15 row_newbcast:8 row_mask:0xf bank_mask:0xf
    v_cvt_pk_bf16_f32 v40, 0, v38
    v_cvt_pk_bf16_f32 v41, v38, 0
    v_lshlrev_b32 v2, 3, v0
    v_add_u32 v2, 81984, v2
    s_cmp_ge_u32 s3, 128
    s_barrier
    ds_read_b128 v[8:11], v36 offset:8192
    ds_read_b128 v[12:15], v36 offset:12288
    s_waitcnt lgkmcnt(2)
    v_dot2c_f32_bf16_dpp v25, v40, v16 row_newbcast:0 row_mask:0xf bank_mask:0xf
    v_dot2c_f32_bf16_dpp v24, v41, v16 row_newbcast:0 row_mask:0xf bank_mask:0xf
    v_dot2c_f32_bf16_dpp v27, v40, v17 row_newbcast:0 row_mask:0xf bank_mask:0xf
    v_dot2c_f32_bf16_dpp v26, v41, v17 row_newbcast:0 row_mask:0xf bank_mask:0xf
    v_dot2c_f32_bf16_dpp v29, v40, v18 row_newbcast:0 row_mask:0xf bank_mask:0xf
    v_dot2c_f32_bf16_dpp v28, v41, v18 row_newbcast:0 row_mask:0xf bank_mask:0xf
    v_dot2c_f32_bf16_dpp v31, v40, v19 row_newbcast:0 row_mask:0xf bank_mask:0xf
    v_dot2c_f32_bf16_dpp v30, v41, v19 row_newbcast:0 row_mask:0xf bank_mask:0xf
    v_dot2c_f32_bf16_dpp v25, v40, v20 row_newbcast:8 row_mask:0xf bank_mask:0xf
    v_dot2c_f32_bf16_dpp v24, v41, v20 row_newbcast:8 row_mask:0xf bank_mask:0xf
    v_dot2c_f32_bf16_dpp v27, v40, v21 row_newbcast:8 row_mask:0xf bank_mask:0xf
    v_dot2c_f32_bf16_dpp v26, v41, v21 row_newbcast:8 row_mask:0xf bank_mask:0xf
    v_dot2c_f32_bf16_dpp v29, v40, v22 row_newbcast:8 row_mask:0xf bank_mask:0xf
    v_dot2c_f32_bf16_dpp v28, v41, v22 row_newbcast:8 row_mask:0xf bank_mask:0xf
    v_dot2c_f32_bf16_dpp v31, v40, v23 row_newbcast:8 row_mask:0xf bank_mask:0xf
    v_dot2c_f32_bf16_dpp v30, v41, v23 row_newbcast:8 row_mask:0xf bank_mask:0xf
    s_barrier
    ds_read_b128 v[16:19], v36 offset:16384
    ds_read_b128 v[20:23], v36 offset:20480
    s_waitcnt lgkmcnt(2)
    v_dot2c_f32_bf16_dpp v25, v46, v8 row_newbcast:0 row_mask:0xf bank_mask:0xf
    v_dot2c_f32_bf16_dpp v24, v47, v8 row_newbcast:0 row_mask:0xf bank_mask:0xf
    v_dot2c_f32_bf16_dpp v27, v46, v9 row_newbcast:0 row_mask:0xf bank_mask:0xf
    v_dot2c_f32_bf16_dpp v26, v47, v9 row_newbcast:0 row_mask:0xf bank_mask:0xf
    v_dot2c_f32_bf16_dpp v29, v46, v10 row_newbcast:0 row_mask:0xf bank_mask:0xf
    v_dot2c_f32_bf16_dpp v28, v47, v10 row_newbcast:0 row_mask:0xf bank_mask:0xf
    v_dot2c_f32_bf16_dpp v31, v46, v11 row_newbcast:0 row_mask:0xf bank_mask:0xf
    v_dot2c_f32_bf16_dpp v30, v47, v11 row_newbcast:0 row_mask:0xf bank_mask:0xf
    v_dot2c_f32_bf16_dpp v25, v46, v12 row_newbcast:8 row_mask:0xf bank_mask:0xf
    v_dot2c_f32_bf16_dpp v24, v47, v12 row_newbcast:8 row_mask:0xf bank_mask:0xf
    v_dot2c_f32_bf16_dpp v27, v46, v13 row_newbcast:8 row_mask:0xf bank_mask:0xf
    v_dot2c_f32_bf16_dpp v26, v47, v13 row_newbcast:8 row_mask:0xf bank_mask:0xf
    v_dot2c_f32_bf16_dpp v29, v46, v14 row_newbcast:8 row_mask:0xf bank_mask:0xf
    v_dot2c_f32_bf16_dpp v28, v47, v14 row_newbcast:8 row_mask:0xf bank_mask:0xf
    v_dot2c_f32_bf16_dpp v31, v46, v15 row_newbcast:8 row_mask:0xf bank_mask:0xf
    v_dot2c_f32_bf16_dpp v30, v47, v15 row_newbcast:8 row_mask:0xf bank_mask:0xf
    s_barrier
    ds_read_b128 v[8:11], v36 offset:24576
    ds_read_b128 v[12:15], v36 offset:28672
    s_waitcnt lgkmcnt(2)
    v_dot2c_f32_bf16_dpp v25, v48, v16 row_newbcast:0 row_mask:0xf bank_mask:0xf
    v_dot2c_f32_bf16_dpp v24, v49, v16 row_newbcast:0 row_mask:0xf bank_mask:0xf
    v_dot2c_f32_bf16_dpp v27, v48, v17 row_newbcast:0 row_mask:0xf bank_mask:0xf
    v_dot2c_f32_bf16_dpp v26, v49, v17 row_newbcast:0 row_mask:0xf bank_mask:0xf
    v_dot2c_f32_bf16_dpp v29, v48, v18 row_newbcast:0 row_mask:0xf bank_mask:0xf
    v_dot2c_f32_bf16_dpp v28, v49, v18 row_newbcast:0 row_mask:0xf bank_mask:0xf
    v_dot2c_f32_bf16_dpp v31, v48, v19 row_newbcast:0 row_mask:0xf bank_mask:0xf
    v_dot2c_f32_bf16_dpp v30, v49, v19 row_newbcast:0 row_mask:0xf bank_mask:0xf
    v_dot2c_f32_bf16_dpp v25, v48, v20 row_newbcast:8 row_mask:0xf bank_mask:0xf
    v_dot2c_f32_bf16_dpp v24, v49, v20 row_newbcast:8 row_mask:0xf bank_mask:0xf
    v_dot2c_f32_bf16_dpp v27, v48, v21 row_newbcast:8 row_mask:0xf bank_mask:0xf
    v_dot2c_f32_bf16_dpp v26, v49, v21 row_newbcast:8 row_mask:0xf bank_mask:0xf
    v_dot2c_f32_bf16_dpp v29, v48, v22 row_newbcast:8 row_mask:0xf bank_mask:0xf
    v_dot2c_f32_bf16_dpp v28, v49, v22 row_newbcast:8 row_mask:0xf bank_mask:0xf
    v_dot2c_f32_bf16_dpp v31, v48, v23 row_newbcast:8 row_mask:0xf bank_mask:0xf
    v_dot2c_f32_bf16_dpp v30, v49, v23 row_newbcast:8 row_mask:0xf bank_mask:0xf
    s_waitcnt lgkmcnt(0)
    v_dot2c_f32_bf16_dpp v25, v50, v8 row_newbcast:0 row_mask:0xf bank_mask:0xf
    v_dot2c_f32_bf16_dpp v24, v51, v8 row_newbcast:0 row_mask:0xf bank_mask:0xf
    v_dot2c_f32_bf16_dpp v27, v50, v9 row_newbcast:0 row_mask:0xf bank_mask:0xf
    v_dot2c_f32_bf16_dpp v26, v51, v9 row_newbcast:0 row_mask:0xf bank_mask:0xf
    v_dot2c_f32_bf16_dpp v29, v50, v10 row_newbcast:0 row_mask:0xf bank_mask:0xf
    v_dot2c_f32_bf16_dpp v28, v51, v10 row_newbcast:0 row_mask:0xf bank_mask:0xf
    v_dot2c_f32_bf16_dpp v31, v50, v11 row_newbcast:0 row_mask:0xf bank_mask:0xf
    v_dot2c_f32_bf16_dpp v30, v51, v11 row_newbcast:0 row_mask:0xf bank_mask:0xf
    v_dot2c_f32_bf16_dpp v25, v50, v12 row_newbcast:8 row_mask:0xf bank_mask:0xf
    v_dot2c_f32_bf16_dpp v24, v51, v12 row_newbcast:8 row_mask:0xf bank_mask:0xf
    v_dot2c_f32_bf16_dpp v27, v50, v13 row_newbcast:8 row_mask:0xf bank_mask:0xf
    v_dot2c_f32_bf16_dpp v26, v51, v13 row_newbcast:8 row_mask:0xf bank_mask:0xf
    v_dot2c_f32_bf16_dpp v29, v50, v14 row_newbcast:8 row_mask:0xf bank_mask:0xf
    v_dot2c_f32_bf16_dpp v28, v51, v14 row_newbcast:8 row_mask:0xf bank_mask:0xf
    v_dot2c_f32_bf16_dpp v31, v50, v15 row_newbcast:8 row_mask:0xf bank_mask:0xf
    v_dot2c_f32_bf16_dpp v30, v51, v15 row_newbcast:8 row_mask:0xf bank_mask:0xf
    s_waitcnt vmcnt(1)
    v_dot2c_f32_bf16_dpp v25, v52, v56 row_newbcast:0 row_mask:0xf bank_mask:0xf
    v_dot2c_f32_bf16_dpp v24, v53, v56 row_newbcast:0 row_mask:0xf bank_mask:0xf
    v_dot2c_f32_bf16_dpp v27, v52, v57 row_newbcast:0 row_mask:0xf bank_mask:0xf
    v_dot2c_f32_bf16_dpp v26, v53, v57 row_newbcast:0 row_mask:0xf bank_mask:0xf
    v_dot2c_f32_bf16_dpp v29, v52, v58 row_newbcast:0 row_mask:0xf bank_mask:0xf
    v_dot2c_f32_bf16_dpp v28, v53, v58 row_newbcast:0 row_mask:0xf bank_mask:0xf
    v_dot2c_f32_bf16_dpp v31, v52, v59 row_newbcast:0 row_mask:0xf bank_mask:0xf
    v_dot2c_f32_bf16_dpp v30, v53, v59 row_newbcast:0 row_mask:0xf bank_mask:0xf
    s_waitcnt vmcnt(0)
    v_dot2c_f32_bf16_dpp v25, v52, v60 row_newbcast:8 row_mask:0xf bank_mask:0xf
    v_dot2c_f32_bf16_dpp v24, v53, v60 row_newbcast:8 row_mask:0xf bank_mask:0xf
    v_dot2c_f32_bf16_dpp v29, v52, v62 row_newbcast:8 row_mask:0xf bank_mask:0xf
    v_dot2c_f32_bf16_dpp v28, v53, v62 row_newbcast:8 row_mask:0xf bank_mask:0xf
    v_dot2c_f32_bf16_dpp v27, v52, v61 row_newbcast:8 row_mask:0xf bank_mask:0xf
    v_dot2c_f32_bf16_dpp v26, v53, v61 row_newbcast:8 row_mask:0xf bank_mask:0xf
    v_dot2c_f32_bf16_dpp v31, v52, v63 row_newbcast:8 row_mask:0xf bank_mask:0xf
    v_dot2c_f32_bf16_dpp v30, v53, v63 row_newbcast:8 row_mask:0xf bank_mask:0xf
    v_permlane32_swap_b32 v25, v29
    v_permlane32_swap_b32 v24, v28
    v_permlane32_swap_b32 v27, v31
    v_permlane32_swap_b32 v26, v30
    v_pk_add_f32 v[24:25], v[24:25], v[28:29]
    s_nop 0
    v_pk_add_f32 v[26:27], v[26:27], v[30:31]
    s_nop 1
    v_permlane16_swap_b32 v24, v26
    v_permlane16_swap_b32 v25, v27
    s_nop 1
    v_pk_add_f32 v[24:25], v[24:25], v[26:27]
    s_cbranch_scc0 L_fin
    ds_write_b64 v2, v[24:25]
    s_waitcnt lgkmcnt(0)
    s_barrier
    s_endpgm
L_fin:
    s_barrier
    ds_read2st64_b64 v[8:11], v2 offset0:1 offset1:2
    ds_read_b64 v[12:13], v2 offset:1536
    s_waitcnt lgkmcnt(0)
    v_pk_add_f32 v[24:25], v[24:25], v[8:9]
    v_pk_add_f32 v[10:11], v[10:11], v[12:13]
    v_pk_add_f32 v[24:25], v[24:25], v[10:11]
    v_cvt_pk_bf16_f32 v24, v24, v25
    global_store_dword v1, v24, s[30:31]
L_end:
    s_endpgm
.section .rodata,"a"
.p2align 6
.amdhsa_kernel standalone__mha_softmax__decode_kernel
  .amdhsa_next_free_vgpr 64
  .amdhsa_next_free_sgpr 32
  .amdhsa_accum_offset 64
  .amdhsa_group_segment_fixed_size 0
  .amdhsa_kernarg_size 48
  .amdhsa_user_sgpr_count 2
  .amdhsa_user_sgpr_kernarg_segment_ptr 1
  .amdhsa_system_sgpr_workgroup_id_x 1
  .amdhsa_float_denorm_mode_32 3
.end_amdhsa_kernel
```
